```python
import torch

def _softmax(x, axis=-1):
    return torch.softmax(x, dim=axis)
def _gelu(x):
    return torch.nn.functional.gelu(x, approximate="tanh")
def _silu(x):
    return torch.nn.functional.silu(x)
def _sigmoid(x):
    return torch.sigmoid(x)
def _layernorm(x, axis=-1, eps=1e-5):
    m = x.mean(dim=axis, keepdim=True)
    v = x.var(dim=axis, keepdim=True, unbiased=False)
    return (x - m) / torch.sqrt(v + eps)
def _scatter_add(tgt, idx, src, axis=0):
    return tgt.clone().index_add_(axis, idx, src)
def _segment_sum(src, seg, n):
    out = torch.zeros((n,) + src.shape[1:], dtype=src.dtype)
    return out.index_add_(0, seg, src)
def _pad(x, pw):
    flat = tuple(v for pair in reversed(pw) for v in pair)
    return torch.nn.functional.pad(x, flat)

kernel_name = 'standalone__linear_kernel_rfa__decode'

def setup_inputs():

    _w = (lambda a: (lambda t: t.to(torch.bfloat16) if t.is_floating_point() else t)(torch.as_tensor(a)))
    B, H, Sq, Sk, D, M = 4, 32, 1, 8192, 128, 16
    return {
        "q": _w((lambda *s: torch.randn(*s, dtype=torch.bfloat16) * 0.4)(B, H, Sq, D)),
        "k": _w((lambda *s: torch.randn(*s, dtype=torch.bfloat16) * 1.6)(B, H, Sk, D)),
        "v": _w((lambda *s: torch.randn(*s, dtype=torch.bfloat16) * 1.6)(B, H, Sk, D)),
        "omega": _w((lambda *s: torch.randn(*s, dtype=torch.bfloat16) * 1.6)(M, D)),
    }

def reference(q, k, v, omega):
    d = q.shape[-1]
    m = omega.shape[0]
    scale = float(d) ** -0.25
    qs = q * scale
    ks = k * scale
    q_proj = torch.einsum("bhsd,md->bhsm", qs, omega)
    k_proj = torch.einsum("bhsd,md->bhsm", ks, omega)
    q_sq = 0.5 * torch.einsum("bhsd,bhsd->bhs", qs, qs)[..., None]
    k_sq = 0.5 * torch.einsum("bhsd,bhsd->bhs", ks, ks)[..., None]
    inv_sqrt_m = float(m) ** -0.5
    phi_q = torch.exp(q_proj - q_sq) * inv_sqrt_m + 1e-6
    phi_k = torch.exp(k_proj - k_sq) * inv_sqrt_m + 1e-6
    kv = torch.einsum("bhsm,bhsd->bhmd", phi_k, v)
    z  = torch.einsum("bhsm->bhm", phi_k)
    num = torch.einsum("bhqm,bhmd->bhqd", phi_q, kv)
    den = torch.einsum("bhqm,bhm->bhq", phi_q, z)[..., None] + 1e-6
    return num / den
```

```asm
; @launch grid=(256,1,1) block=(320,1,1) lds=42048
.amdgcn_target "amdgcn-amd-amdhsa--gfx950"
.text
.globl standalone__linear_kernel_rfa__decode_kernel
.p2align 8
.type standalone__linear_kernel_rfa__decode_kernel,@function
standalone__linear_kernel_rfa__decode_kernel:
    s_load_dwordx4 s[4:7], s[0:1], 8
    s_cmp_ge_u32 s2, 256
    s_cbranch_scc1 L_end
    v_lshrrev_b32 v12, 6, v0
    v_and_b32 v0, 63, v0
    v_readfirstlane_b32 s25, v12
    v_lshrrev_b32 v13, 4, v0
    v_and_b32 v14, 15, v0
    v_lshlrev_b32 v21, 4, v0
    s_lshr_b32 s3, s2, 1
    s_mov_b32 s23, s3
    s_and_b32 s3, s23, 22
    s_lshr_b32 s3, s3, 1
    s_and_b32 s24, s23, 96
    s_or_b32 s3, s3, s24
    s_and_b32 s24, s23, 8
    s_lshl_b32 s24, s24, 1
    s_or_b32 s3, s3, s24
    s_and_b32 s24, s23, 1
    s_lshl_b32 s24, s24, 2
    s_or_b32 s3, s3, s24
    s_cmp_eq_u32 s25, 4
    s_cbranch_scc1 L_helper0
L_stream:
    v_and_b32 v15, 1, v13
    v_lshlrev_b32 v15, 13, v15
    v_lshl_add_u32 v15, v14, 4, v15
    v_lshrrev_b32 v16, 1, v13
    v_lshl_add_u32 v5, v16, 15, v15
    v_lshlrev_b32 v15, 6, v13
    v_xor_b32 v1, v15, v5
    s_lshl_b32 s3, s3, 21
    s_and_b32 s16, s2, 1
    s_lshl_b32 s16, s16, 9
    s_and_b32 s17, s25, 1
    s_lshl_b32 s17, s17, 10
    s_or_b32 s16, s16, s17
    s_lshr_b32 s17, s25, 1
    s_lshl_b32 s17, s17, 16
    s_or_b32 s16, s16, s17
    s_lshl_b32 s20, s25, 13
    s_mov_b32 s10, 0x200000
    s_mov_b32 s11, 0x20000
    s_add_u32 m0, s20, 0
    s_waitcnt lgkmcnt(0)
    s_add_u32 s8, s4, s3
    s_addc_u32 s9, s5, 0
    buffer_load_dwordx4 v1, s[8:11], s16 offen nt lds
    v_xor_b32 v2, 1048592, v1
    v_xor_b32 v3, 2080, v1
    v_xor_b32 v4, 1050672, v1
    s_or_b32 s17, s16, 256
    s_mov_b32 s18, s16
    s_mov_b32 s19, s17
    s_mov_b32 s14, 0x200000
    s_mov_b32 s15, 0x20000
    s_add_u32 m0, s20, 1024
    s_nop 0
    buffer_load_dwordx4 v2, s[8:11], s16 offen nt lds
    s_add_u32 m0, s20, 2048
    s_nop 0
    buffer_load_dwordx4 v3, s[8:11], s16 offen nt lds
    s_add_u32 m0, s20, 3072
    s_nop 0
    buffer_load_dwordx4 v4, s[8:11], s16 offen nt lds
    s_or_b32 s75, s16, 0xfff1afff
    s_add_u32 s75, s75, 1
    s_and_b32 s75, s75, 0xe5000
    s_andn2_b32 s16, s16, 0xe5000
    s_or_b32 s16, s16, s75
    s_add_u32 s12, s6, s3
    s_addc_u32 s13, s7, 0
    s_add_u32 m0, s20, 4096
    s_nop 0
    buffer_load_dwordx4 v1, s[8:11], s17 offen nt lds
    s_mov_b32 s73, 0x9311254
    s_bitcmp1_b32 s2, 0
    s_cselect_b32 s74, 0x54, 0
    s_and_b32 s74, s74, s73
    s_andn2_b32 s73, s73, s74
    s_mov_b64 vcc, 0
    v_and_b32 v15, 3, v14
    v_lshlrev_b32 v15, 10, v15
    v_lshrrev_b32 v16, 2, v14
    v_lshl_add_u32 v15, v16, 8, v15
    v_xor_b32 v16, v13, v14
    v_lshl_add_u32 v15, v16, 4, v15
    v_add_u32 v6, s20, v15
    v_xor_b32 v7, 64, v6
    v_xor_b32 v8, 128, v6
    v_xor_b32 v9, 192, v6
    s_mov_b32 s26, 0x3e9837f0
    s_mov_b32 s27, 0x3e9837f0
    s_mov_b32 s28, 0x3fb8aa3b
    v_mov_b32 v10, 0x35860000
    s_mov_b32 s29, 0x05040100
    s_mov_b32 s30, 0x07060302
    s_mov_b32 s32, 0x100001
    s_mov_b32 s33, 0x10000100
    s_mov_b32 s34, 0x200002
    s_mov_b32 s35, 0x20000200
    s_mov_b32 s36, 0x400004
    s_mov_b32 s37, 0x40000400
    s_mov_b32 s38, 0x800008
    s_mov_b32 s39, 0x80000800
    v_mov_b32 v11, -0.5
    v_mov_b32 v172, 0x3f803f80
    v_mov_b32 v173, 0x3f803f80
    v_mov_b32 v174, 0x3f803f80
    v_mov_b32 v175, 0x3f803f80
    v_mov_b32 v136, 0
    v_mov_b32 v137, 0
    v_mov_b32 v138, 0
    v_mov_b32 v139, 0
    v_mov_b32 v140, 0
    v_mov_b32 v141, 0
    v_mov_b32 v142, 0
    v_mov_b32 v143, 0
    v_mov_b32 v144, 0
    v_mov_b32 v145, 0
    v_mov_b32 v146, 0
    v_mov_b32 v147, 0
    v_mov_b32 v148, 0
    v_mov_b32 v149, 0
    v_mov_b32 v150, 0
    v_mov_b32 v151, 0
    v_mov_b32 v152, 0
    v_mov_b32 v153, 0
    v_mov_b32 v154, 0
    v_mov_b32 v155, 0
    v_mov_b32 v156, 0
    v_mov_b32 v157, 0
    v_mov_b32 v158, 0
    v_mov_b32 v159, 0
    v_mov_b32 v160, 0
    v_mov_b32 v161, 0
    v_mov_b32 v162, 0
    v_mov_b32 v163, 0
    v_mov_b32 v164, 0
    v_mov_b32 v165, 0
    v_mov_b32 v166, 0
    v_mov_b32 v167, 0
    v_mov_b32 v168, 0
    v_mov_b32 v169, 0
    v_mov_b32 v170, 0
    v_mov_b32 v171, 0
    s_lshl_b32 s50, s25, 10
    v_add_u32 v22, s50, v21
    s_mov_b32 s22, 31
    v_mov_b32 v0, 0
    v_mov_b32 v23, 255
    s_mov_b32 s76, 127
    s_mov_b32 s71, 255
    ds_write_b32 v0, v23 offset:41984
    s_add_u32 m0, s20, 5120
    s_waitcnt vmcnt(4)
    buffer_load_dwordx4 v2, s[8:11], s17 offen nt lds
    s_branch L_loop
L_helper0:
    s_getpc_b64 s[12:13]
L_pc0:
    s_sub_u32 s12, s12, L_pc0-standalone__linear_kernel_rfa__decode_kernel
    s_subb_u32 s13, s13, 0
    v_lshlrev_b32 v18, 6, v0
    global_load_dword v19, v18, s[12:13]
    v_add_u32 v18, 4096, v18
    v_min_u32 v18, L_end-standalone__linear_kernel_rfa__decode_kernel, v18
    global_load_dword v19, v18, s[12:13]
    s_load_dwordx2 s[46:47], s[0:1], 0
    s_load_dwordx2 s[8:9], s[0:1], 24
    s_load_dwordx2 s[44:45], s[0:1], 32
    s_load_dwordx4 s[40:43], s[0:1], 40
    v_lshlrev_b32 v16, 4, v13
    v_lshl_add_u32 v17, v14, 8, v16
    v_lshlrev_b32 v23, 4, v14
    v_lshl_add_u32 v23, v13, 2, v23
    s_mov_b32 s10, 4096
    s_mov_b32 s11, 0x20000
    s_lshl_b32 s50, s3, 8
    s_mul_i32 s51, s3, 1024
    s_waitcnt lgkmcnt(0)
    s_mov_b32 m0, 32768
    s_nop 0
    buffer_load_dwordx4 v17, s[8:11], 0 offen offset:0 lds
    s_mov_b32 m0, 33728
    s_nop 0
    buffer_load_dwordx4 v17, s[8:11], 0 offen offset:64 lds
    s_mov_b32 m0, 34688
    s_nop 0
    buffer_load_dwordx4 v17, s[8:11], 0 offen offset:128 lds
    s_mov_b32 m0, 35648
    s_nop 0
    buffer_load_dwordx4 v17, s[8:11], 0 offen offset:192 lds
    s_branch L_helper
.p2align 6
L_loop:
    s_add_u32 m0, s20, 6144
    s_waitcnt vmcnt(5)
    s_cbranch_vccnz L_t0
    s_waitcnt vmcnt(4)
L_t0:
    buffer_load_dwordx4 v3, s[8:11], s17 offen nt lds
    s_bitcmp1_b32 s73, s22
    s_cbranch_scc0 L_nba
    s_barrier
L_nba:
    s_sub_u32 s76, s76, 1
    s_cmp_gt_u32 s76, s71
    s_cselect_b64 vcc, -1, 0
    s_add_u32 m0, s20, 7168
    s_waitcnt vmcnt(5)
    s_cbranch_vccnz L_t1
    s_waitcnt vmcnt(4)
L_t1:
    buffer_load_dwordx4 v4, s[8:11], s17 offen nt lds
    s_or_b32 s75, s17, 0xfff1afff
    s_add_u32 s75, s75, 1
    s_and_b32 s75, s75, 0xe5000
    s_andn2_b32 s17, s17, 0xe5000
    s_or_b32 s17, s17, s75
    s_waitcnt vmcnt(5)
    s_cbranch_vccnz L_t2
    s_waitcnt vmcnt(4)
L_t2:
    buffer_load_dwordx4 v[72:75], v5, s[12:15], s18 offen offset:0 nt
    s_add_u32 s53, s18, 1048576
    s_waitcnt vmcnt(5)
    s_cbranch_vccnz L_t3
    s_waitcnt vmcnt(4)
L_t3:
    buffer_load_dwordx4 v[76:79], v5, s[12:15], s53 offen offset:0 nt
    s_cmp_lg_u32 s22, 31
    s_cbranch_scc1 L_noom
    s_waitcnt lgkmcnt(0)
    s_barrier
    ds_read_b128 v[24:27], v21 offset:32768
    ds_read_b128 v[28:31], v21 offset:33792
    ds_read_b128 v[32:35], v21 offset:34816
    ds_read_b128 v[36:39], v21 offset:35840
L_noom:
    ds_read_b128 v[40:43], v6 offset:0
    ds_read_b128 v[44:47], v7 offset:0
    ds_read_b128 v[48:51], v8 offset:0
    ds_read_b128 v[52:55], v9 offset:0
    ds_read_b32 v23, v0 offset:41984
    s_waitcnt vmcnt(5)
    s_cbranch_vccnz L_t4
    s_waitcnt vmcnt(4)
L_t4:
    buffer_load_dwordx4 v[80:83], v5, s[12:15], s18 offen offset:2048 nt
    s_bitcmp1_b32 s74, s22
    s_cbranch_scc0 L_nbb
    s_barrier
L_nbb:
    s_waitcnt lgkmcnt(0)
    v_readfirstlane_b32 s71, v23
    s_sub_u32 s76, s76, 1
    s_cmp_gt_u32 s76, s71
    s_cselect_b64 vcc, -1, 0
    v_lshlrev_b32 v12, 16, v40
    v_and_b32 v13, 0xffff0000, v40
    v_lshlrev_b32 v14, 16, v41
    v_and_b32 v15, 0xffff0000, v41
    v_lshlrev_b32 v16, 16, v42
    v_and_b32 v17, 0xffff0000, v42
    v_lshlrev_b32 v18, 16, v43
    v_and_b32 v19, 0xffff0000, v43
    v_pk_mul_f32 v[12:13], v[12:13], s[26:27]
    v_pk_mul_f32 v[14:15], v[14:15], s[26:27]
    v_pk_mul_f32 v[16:17], v[16:17], s[26:27]
    v_pk_mul_f32 v[18:19], v[18:19], s[26:27]
    v_cvt_pk_bf16_f32 v40, v12, v13
    v_cvt_pk_bf16_f32 v41, v14, v15
    v_cvt_pk_bf16_f32 v42, v16, v17
    v_cvt_pk_bf16_f32 v43, v18, v19
    v_lshlrev_b32 v12, 16, v44
    s_add_u32 s53, s18, 1048576
    s_waitcnt vmcnt(5)
    s_cbranch_vccnz L_t5
    s_waitcnt vmcnt(4)
L_t5:
    buffer_load_dwordx4 v[84:87], v5, s[12:15], s53 offen offset:2048 nt
    s_or_b32 s75, s18, 0xfff1afff
    s_add_u32 s75, s75, 1
    s_and_b32 s75, s75, 0xe5000
    s_andn2_b32 s18, s18, 0xe5000
    s_or_b32 s18, s18, s75
    v_and_b32 v13, 0xffff0000, v44
    v_mfma_f32_16x16x32_bf16 v[180:183], v[40:43], v[40:43], 0
    v_mfma_f32_16x16x32_bf16 v[176:179], v[40:43], v[24:27], 0
    v_lshlrev_b32 v14, 16, v45
    v_and_b32 v15, 0xffff0000, v45
    v_lshlrev_b32 v16, 16, v46
    v_and_b32 v17, 0xffff0000, v46
    v_lshlrev_b32 v18, 16, v47
    v_and_b32 v19, 0xffff0000, v47
    v_pk_mul_f32 v[12:13], v[12:13], s[26:27]
    v_pk_mul_f32 v[14:15], v[14:15], s[26:27]
    v_pk_mul_f32 v[16:17], v[16:17], s[26:27]
    v_pk_mul_f32 v[18:19], v[18:19], s[26:27]
    v_cvt_pk_bf16_f32 v44, v12, v13
    v_cvt_pk_bf16_f32 v45, v14, v15
    v_cvt_pk_bf16_f32 v46, v16, v17
    v_cvt_pk_bf16_f32 v47, v18, v19
    v_lshlrev_b32 v12, 16, v48
    s_waitcnt vmcnt(5)
    s_cbranch_vccnz L_t6
    s_waitcnt vmcnt(4)
L_t6:
    buffer_load_dwordx4 v[88:91], v5, s[12:15], s19 offen offset:0 nt
    v_and_b32 v13, 0xffff0000, v48
    v_mfma_f32_16x16x32_bf16 v[180:183], v[44:47], v[44:47], v[180:183]
    v_mfma_f32_16x16x32_bf16 v[176:179], v[44:47], v[28:31], v[176:179]
    v_lshlrev_b32 v14, 16, v49
    v_and_b32 v15, 0xffff0000, v49
    v_lshlrev_b32 v16, 16, v50
    v_and_b32 v17, 0xffff0000, v50
    v_lshlrev_b32 v18, 16, v51
    v_and_b32 v19, 0xffff0000, v51
    v_pk_mul_f32 v[12:13], v[12:13], s[26:27]
    v_pk_mul_f32 v[14:15], v[14:15], s[26:27]
    v_pk_mul_f32 v[16:17], v[16:17], s[26:27]
    v_pk_mul_f32 v[18:19], v[18:19], s[26:27]
    v_cvt_pk_bf16_f32 v48, v12, v13
    v_cvt_pk_bf16_f32 v49, v14, v15
    v_cvt_pk_bf16_f32 v50, v16, v17
    v_cvt_pk_bf16_f32 v51, v18, v19
    v_lshlrev_b32 v12, 16, v52
    s_add_u32 s53, s19, 1048576
    s_waitcnt vmcnt(5)
    s_cbranch_vccnz L_t7
    s_waitcnt vmcnt(4)
L_t7:
    buffer_load_dwordx4 v[92:95], v5, s[12:15], s53 offen offset:0 nt
    ds_read_b32 v23, v0 offset:41984
    ds_read_b128 v[56:59], v6 offset:4096
    ds_read_b128 v[60:63], v7 offset:4096
    ds_read_b128 v[64:67], v8 offset:4096
    ds_read_b128 v[68:71], v9 offset:4096
    v_and_b32 v13, 0xffff0000, v52
    v_mfma_f32_16x16x32_bf16 v[180:183], v[48:51], v[48:51], v[180:183]
    v_mfma_f32_16x16x32_bf16 v[176:179], v[48:51], v[32:35], v[176:179]
    v_lshlrev_b32 v14, 16, v53
    v_and_b32 v15, 0xffff0000, v53
    v_lshlrev_b32 v16, 16, v54
    v_and_b32 v17, 0xffff0000, v54
    v_lshlrev_b32 v18, 16, v55
    v_and_b32 v19, 0xffff0000, v55
    v_pk_mul_f32 v[12:13], v[12:13], s[26:27]
    v_pk_mul_f32 v[14:15], v[14:15], s[26:27]
    v_pk_mul_f32 v[16:17], v[16:17], s[26:27]
    v_pk_mul_f32 v[18:19], v[18:19], s[26:27]
    v_cvt_pk_bf16_f32 v52, v12, v13
    v_cvt_pk_bf16_f32 v53, v14, v15
    v_cvt_pk_bf16_f32 v54, v16, v17
    v_cvt_pk_bf16_f32 v55, v18, v19
    s_nop 1
    v_mfma_f32_16x16x32_bf16 v[180:183], v[52:55], v[52:55], v[180:183]
    v_mfma_f32_16x16x32_bf16 v[176:179], v[52:55], v[36:39], v[176:179]
    s_waitcnt vmcnt(5)
    s_cbranch_vccnz L_t8
    s_waitcnt vmcnt(4)
L_t8:
    buffer_load_dwordx4 v[96:99], v5, s[12:15], s19 offen offset:2048 nt
    s_waitcnt lgkmcnt(0)
    v_readfirstlane_b32 s71, v23
    s_sub_u32 s76, s76, 1
    s_cmp_gt_u32 s76, s71
    s_cselect_b64 vcc, -1, 0
    v_lshlrev_b32 v12, 16, v56
    v_and_b32 v13, 0xffff0000, v56
    v_lshlrev_b32 v14, 16, v57
    v_and_b32 v15, 0xffff0000, v57
    v_lshlrev_b32 v16, 16, v58
    v_and_b32 v17, 0xffff0000, v58
    v_cndmask_b32 v20, 0, v180, s[32:33]
    v_cndmask_b32 v20, v20, v181, s[34:35]
    v_cndmask_b32 v20, v20, v182, s[36:37]
    v_cndmask_b32 v20, v20, v183, s[38:39]
    v_cvt_pk_bf16_f32 v20, 0, v20
    v_cvt_pk_bf16_f32 v176, 0, v176
    v_cvt_pk_bf16_f32 v177, 0, v177
    v_cvt_pk_bf16_f32 v178, 0, v178
    v_cvt_pk_bf16_f32 v179, 0, v179
    v_lshlrev_b32 v18, 16, v59
    v_and_b32 v19, 0xffff0000, v59
    v_mfma_f32_16x16x4_f32 v[176:179], v20, v11, v[176:179]
    v_pk_mul_f32 v[12:13], v[12:13], s[26:27]
    v_pk_mul_f32 v[14:15], v[14:15], s[26:27]
    s_add_u32 s53, s19, 1048576
    s_waitcnt vmcnt(5)
    s_cbranch_vccnz L_t9
    s_waitcnt vmcnt(4)
L_t9:
    buffer_load_dwordx4 v[100:103], v5, s[12:15], s53 offen offset:2048 nt
    s_or_b32 s75, s19, 0xfff1afff
    s_add_u32 s75, s75, 1
    s_and_b32 s75, s75, 0xe5000
    s_andn2_b32 s19, s19, 0xe5000
    s_or_b32 s19, s19, s75
    v_pk_mul_f32 v[16:17], v[16:17], s[26:27]
    v_pk_mul_f32 v[18:19], v[18:19], s[26:27]
    v_cvt_pk_bf16_f32 v56, v12, v13
    v_cvt_pk_bf16_f32 v57, v14, v15
    v_cvt_pk_bf16_f32 v58, v16, v17
    v_cvt_pk_bf16_f32 v59, v18, v19
    v_lshlrev_b32 v12, 16, v60
    v_and_b32 v13, 0xffff0000, v60
    v_cvt_pk_bf16_f32 v176, 0, v176
    v_cvt_pk_bf16_f32 v177, 0, v177
    v_cvt_pk_bf16_f32 v178, 0, v178
    v_cvt_pk_bf16_f32 v179, 0, v179
    v_mul_f32 v176, s28, v176
    v_mul_f32 v177, s28, v177
    v_mul_f32 v178, s28, v178
    v_mul_f32 v179, s28, v179
    v_exp_f32 v176, v176
    v_exp_f32 v177, v177
    v_exp_f32 v178, v178
    v_exp_f32 v179, v179
    v_cvt_pk_bf16_f32 v176, 0, v176
    v_perm_b32 v104, v76, v72, s29
    v_perm_b32 v108, v76, v72, s30
    v_perm_b32 v112, v77, v73, s29
    v_perm_b32 v116, v77, v73, s30
    v_perm_b32 v120, v78, v74, s29
    v_perm_b32 v124, v78, v74, s30
    v_perm_b32 v128, v79, v75, s29
    v_perm_b32 v132, v79, v75, s30
    s_add_u32 m0, s20, 0
    s_waitcnt vmcnt(5)
    s_cbranch_vccnz L_t10
    s_waitcnt vmcnt(4)
L_t10:
    buffer_load_dwordx4 v1, s[8:11], s16 offen nt lds
    v_cvt_pk_bf16_f32 v177, 0, v177
    v_cvt_pk_bf16_f32 v178, 0, v178
    v_cvt_pk_bf16_f32 v179, 0, v179
    v_fmamk_f32 v176, v176, 0x3e800000, v10
    v_fmamk_f32 v177, v177, 0x3e800000, v10
    v_fmamk_f32 v178, v178, 0x3e800000, v10
    v_fmamk_f32 v179, v179, 0x3e800000, v10
    v_cvt_pk_bf16_f32 v192, v176, v177
    v_cvt_pk_bf16_f32 v193, v178, v179
    v_mfma_f32_16x16x32_bf16 v[188:191], v[56:59], v[56:59], 0
    v_mfma_f32_16x16x32_bf16 v[184:187], v[56:59], v[24:27], 0
    v_lshlrev_b32 v14, 16, v61
    v_and_b32 v15, 0xffff0000, v61
    v_lshlrev_b32 v16, 16, v62
    v_and_b32 v17, 0xffff0000, v62
    v_lshlrev_b32 v18, 16, v63
    v_and_b32 v19, 0xffff0000, v63
    v_pk_mul_f32 v[12:13], v[12:13], s[26:27]
    v_pk_mul_f32 v[14:15], v[14:15], s[26:27]
    v_pk_mul_f32 v[16:17], v[16:17], s[26:27]
    v_pk_mul_f32 v[18:19], v[18:19], s[26:27]
    s_add_u32 m0, s20, 1024
    s_waitcnt vmcnt(5)
    s_cbranch_vccnz L_t11
    s_waitcnt vmcnt(4)
L_t11:
    buffer_load_dwordx4 v2, s[8:11], s16 offen nt lds
    v_cvt_pk_bf16_f32 v60, v12, v13
    v_cvt_pk_bf16_f32 v61, v14, v15
    v_cvt_pk_bf16_f32 v62, v16, v17
    v_cvt_pk_bf16_f32 v63, v18, v19
    v_lshlrev_b32 v12, 16, v64
    v_and_b32 v13, 0xffff0000, v64
    v_mfma_f32_16x16x32_bf16 v[188:191], v[60:63], v[60:63], v[188:191]
    v_mfma_f32_16x16x32_bf16 v[184:187], v[60:63], v[28:31], v[184:187]
    v_lshlrev_b32 v14, 16, v65
    v_and_b32 v15, 0xffff0000, v65
    v_lshlrev_b32 v16, 16, v66
    v_and_b32 v17, 0xffff0000, v66
    v_lshlrev_b32 v18, 16, v67
    v_and_b32 v19, 0xffff0000, v67
    v_pk_mul_f32 v[12:13], v[12:13], s[26:27]
    v_pk_mul_f32 v[14:15], v[14:15], s[26:27]
    v_pk_mul_f32 v[16:17], v[16:17], s[26:27]
    v_pk_mul_f32 v[18:19], v[18:19], s[26:27]
    v_cvt_pk_bf16_f32 v64, v12, v13
    v_cvt_pk_bf16_f32 v65, v14, v15
    v_cvt_pk_bf16_f32 v66, v16, v17
    v_perm_b32 v105, v84, v80, s29
    v_perm_b32 v109, v84, v80, s30
    v_perm_b32 v113, v85, v81, s29
    v_perm_b32 v117, v85, v81, s30
    v_perm_b32 v121, v86, v82, s29
    v_perm_b32 v125, v86, v82, s30
    v_perm_b32 v129, v87, v83, s29
    v_perm_b32 v133, v87, v83, s30
    s_add_u32 m0, s20, 2048
    s_waitcnt vmcnt(5)
    s_cbranch_vccnz L_t12
    s_waitcnt vmcnt(4)
L_t12:
    buffer_load_dwordx4 v3, s[8:11], s16 offen nt lds
    v_cvt_pk_bf16_f32 v67, v18, v19
    v_lshlrev_b32 v12, 16, v68
    v_and_b32 v13, 0xffff0000, v68
    v_mfma_f32_16x16x32_bf16 v[188:191], v[64:67], v[64:67], v[188:191]
    v_mfma_f32_16x16x32_bf16 v[184:187], v[64:67], v[32:35], v[184:187]
    v_lshlrev_b32 v14, 16, v69
    v_and_b32 v15, 0xffff0000, v69
    v_lshlrev_b32 v16, 16, v70
    v_and_b32 v17, 0xffff0000, v70
    v_lshlrev_b32 v18, 16, v71
    v_and_b32 v19, 0xffff0000, v71
    v_pk_mul_f32 v[12:13], v[12:13], s[26:27]
    v_pk_mul_f32 v[14:15], v[14:15], s[26:27]
    v_pk_mul_f32 v[16:17], v[16:17], s[26:27]
    v_pk_mul_f32 v[18:19], v[18:19], s[26:27]
    v_cvt_pk_bf16_f32 v68, v12, v13
    v_cvt_pk_bf16_f32 v69, v14, v15
    v_cvt_pk_bf16_f32 v70, v16, v17
    v_cvt_pk_bf16_f32 v71, v18, v19
    s_nop 1
    v_mfma_f32_16x16x32_bf16 v[188:191], v[68:71], v[68:71], v[188:191]
    v_mfma_f32_16x16x32_bf16 v[184:187], v[68:71], v[36:39], v[184:187]
    s_sub_u32 s76, s76, 1
    s_cmp_gt_u32 s76, s71
    s_cselect_b64 vcc, -1, 0
    s_add_u32 m0, s20, 3072
    s_waitcnt vmcnt(5)
    s_cbranch_vccnz L_t13
    s_waitcnt vmcnt(4)
L_t13:
    buffer_load_dwordx4 v4, s[8:11], s16 offen nt lds
    s_or_b32 s75, s16, 0xfff1afff
    s_add_u32 s75, s75, 1
    s_and_b32 s75, s75, 0xe5000
    s_andn2_b32 s16, s16, 0xe5000
    s_or_b32 s16, s16, s75
    v_cndmask_b32 v20, 0, v188, s[32:33]
    v_cndmask_b32 v20, v20, v189, s[34:35]
    v_cndmask_b32 v20, v20, v190, s[36:37]
    v_cndmask_b32 v20, v20, v191, s[38:39]
    v_cvt_pk_bf16_f32 v20, 0, v20
    v_cvt_pk_bf16_f32 v184, 0, v184
    v_cvt_pk_bf16_f32 v185, 0, v185
    v_cvt_pk_bf16_f32 v186, 0, v186
    v_cvt_pk_bf16_f32 v187, 0, v187
    s_nop 1
    v_mfma_f32_16x16x4_f32 v[184:187], v20, v11, v[184:187]
    s_nop 9
    v_cvt_pk_bf16_f32 v184, 0, v184
    v_cvt_pk_bf16_f32 v185, 0, v185
    v_cvt_pk_bf16_f32 v186, 0, v186
    v_cvt_pk_bf16_f32 v187, 0, v187
    v_mul_f32 v184, s28, v184
    v_mul_f32 v185, s28, v185
    v_perm_b32 v106, v92, v88, s29
    v_perm_b32 v110, v92, v88, s30
    v_perm_b32 v114, v93, v89, s29
    v_perm_b32 v118, v93, v89, s30
    v_perm_b32 v122, v94, v90, s29
    v_perm_b32 v126, v94, v90, s30
    v_perm_b32 v130, v95, v91, s29
    v_perm_b32 v134, v95, v91, s30
    s_add_u32 m0, s20, 4096
    s_waitcnt vmcnt(5)
    s_cbranch_vccnz L_t14
    s_waitcnt vmcnt(4)
L_t14:
    buffer_load_dwordx4 v1, s[8:11], s17 offen nt lds
    v_mul_f32 v186, s28, v186
    v_mul_f32 v187, s28, v187
    v_exp_f32 v184, v184
    v_exp_f32 v185, v185
    v_exp_f32 v186, v186
    v_exp_f32 v187, v187
    v_cvt_pk_bf16_f32 v184, 0, v184
    v_cvt_pk_bf16_f32 v185, 0, v185
    v_cvt_pk_bf16_f32 v186, 0, v186
    v_cvt_pk_bf16_f32 v187, 0, v187
    v_fmamk_f32 v184, v184, 0x3e800000, v10
    v_fmamk_f32 v185, v185, 0x3e800000, v10
    v_fmamk_f32 v186, v186, 0x3e800000, v10
    v_fmamk_f32 v187, v187, 0x3e800000, v10
    v_cvt_pk_bf16_f32 v194, v184, v185
    v_cvt_pk_bf16_f32 v195, v186, v187
    s_nop 1
    v_mfma_f32_16x16x32_bf16 v[168:171], v[192:195], v[172:175], v[168:171]
    s_add_u32 m0, s20, 5120
    s_waitcnt vmcnt(5)
    s_cbranch_vccnz L_t15
    s_waitcnt vmcnt(4)
L_t15:
    buffer_load_dwordx4 v2, s[8:11], s17 offen nt lds
    v_perm_b32 v107, v100, v96, s29
    v_perm_b32 v111, v100, v96, s30
    v_perm_b32 v115, v101, v97, s29
    v_perm_b32 v119, v101, v97, s30
    v_mfma_f32_16x16x32_bf16 v[136:139], v[192:195], v[104:107], v[136:139]
    v_perm_b32 v123, v102, v98, s29
    v_mfma_f32_16x16x32_bf16 v[140:143], v[192:195], v[108:111], v[140:143]
    v_perm_b32 v127, v102, v98, s30
    v_mfma_f32_16x16x32_bf16 v[144:147], v[192:195], v[112:115], v[144:147]
    v_perm_b32 v131, v103, v99, s29
    v_mfma_f32_16x16x32_bf16 v[148:151], v[192:195], v[116:119], v[148:151]
    v_perm_b32 v135, v103, v99, s30
    v_mfma_f32_16x16x32_bf16 v[152:155], v[192:195], v[120:123], v[152:155]
    v_mfma_f32_16x16x32_bf16 v[156:159], v[192:195], v[124:127], v[156:159]
    v_mfma_f32_16x16x32_bf16 v[160:163], v[192:195], v[128:131], v[160:163]
    v_mfma_f32_16x16x32_bf16 v[164:167], v[192:195], v[132:135], v[164:167]
    s_sub_u32 s22, s22, 1
    s_cmp_lg_u32 s22, 0
    s_cbranch_scc1 L_loop
    s_add_u32 m0, s20, 6144
    s_waitcnt vmcnt(5)
    buffer_load_dwordx4 v3, s[8:11], s17 offen nt lds
    s_add_u32 m0, s20, 7168
    s_nop 0
    buffer_load_dwordx4 v4, s[8:11], s17 offen nt lds
    buffer_load_dwordx4 v[72:75], v5, s[12:15], s18 offen offset:0 nt
    s_barrier
    ds_read_b128 v[196:199], v21 offset:40960
    s_add_u32 s53, s18, 1048576
    s_waitcnt vmcnt(7)
    buffer_load_dwordx4 v[76:79], v5, s[12:15], s53 offen offset:0 nt
    s_mov_b32 s82, 0x22222222
    s_mov_b32 s83, 0x22222222
    s_mov_b32 s84, 0x44444444
    s_mov_b32 s85, 0x44444444
    s_mov_b32 s86, 0x88888888
    s_mov_b32 s87, 0x88888888
    s_waitcnt vmcnt(7)
    buffer_load_dwordx4 v[80:83], v5, s[12:15], s18 offen offset:2048 nt
    s_add_u32 s53, s18, 1048576
    s_waitcnt vmcnt(7)
    buffer_load_dwordx4 v[84:87], v5, s[12:15], s53 offen offset:2048 nt
    ds_read_b128 v[40:43], v6 offset:0
    ds_read_b128 v[44:47], v7 offset:0
    ds_read_b128 v[48:51], v8 offset:0
    ds_read_b128 v[52:55], v9 offset:0
    s_waitcnt lgkmcnt(0)
    v_lshlrev_b32 v12, 16, v40
    v_and_b32 v13, 0xffff0000, v40
    v_lshlrev_b32 v14, 16, v41
    v_and_b32 v15, 0xffff0000, v41
    v_lshlrev_b32 v16, 16, v42
    v_and_b32 v17, 0xffff0000, v42
    v_lshlrev_b32 v18, 16, v43
    v_and_b32 v19, 0xffff0000, v43
    v_pk_mul_f32 v[12:13], v[12:13], s[26:27]
    v_pk_mul_f32 v[14:15], v[14:15], s[26:27]
    v_pk_mul_f32 v[16:17], v[16:17], s[26:27]
    v_pk_mul_f32 v[18:19], v[18:19], s[26:27]
    v_cvt_pk_bf16_f32 v40, v12, v13
    v_cvt_pk_bf16_f32 v41, v14, v15
    v_cvt_pk_bf16_f32 v42, v16, v17
    v_cvt_pk_bf16_f32 v43, v18, v19
    v_lshlrev_b32 v12, 16, v44
    v_and_b32 v13, 0xffff0000, v44
    v_mfma_f32_16x16x32_bf16 v[180:183], v[40:43], v[40:43], 0
    v_mfma_f32_16x16x32_bf16 v[176:179], v[40:43], v[24:27], 0
    v_lshlrev_b32 v14, 16, v45
    v_and_b32 v15, 0xffff0000, v45
    v_lshlrev_b32 v16, 16, v46
    v_and_b32 v17, 0xffff0000, v46
    v_lshlrev_b32 v18, 16, v47
    v_and_b32 v19, 0xffff0000, v47
    v_pk_mul_f32 v[12:13], v[12:13], s[26:27]
    v_pk_mul_f32 v[14:15], v[14:15], s[26:27]
    v_pk_mul_f32 v[16:17], v[16:17], s[26:27]
    v_pk_mul_f32 v[18:19], v[18:19], s[26:27]
    v_cvt_pk_bf16_f32 v44, v12, v13
    v_cvt_pk_bf16_f32 v45, v14, v15
    v_cvt_pk_bf16_f32 v46, v16, v17
    v_cvt_pk_bf16_f32 v47, v18, v19
    v_lshlrev_b32 v12, 16, v48
    v_and_b32 v13, 0xffff0000, v48
    v_mfma_f32_16x16x32_bf16 v[180:183], v[44:47], v[44:47], v[180:183]
    v_mfma_f32_16x16x32_bf16 v[176:179], v[44:47], v[28:31], v[176:179]
    v_lshlrev_b32 v14, 16, v49
    v_and_b32 v15, 0xffff0000, v49
    v_lshlrev_b32 v16, 16, v50
    v_and_b32 v17, 0xffff0000, v50
    v_lshlrev_b32 v18, 16, v51
    v_and_b32 v19, 0xffff0000, v51
    v_pk_mul_f32 v[12:13], v[12:13], s[26:27]
    v_pk_mul_f32 v[14:15], v[14:15], s[26:27]
    v_pk_mul_f32 v[16:17], v[16:17], s[26:27]
    v_pk_mul_f32 v[18:19], v[18:19], s[26:27]
    v_cvt_pk_bf16_f32 v48, v12, v13
    v_cvt_pk_bf16_f32 v49, v14, v15
    v_cvt_pk_bf16_f32 v50, v16, v17
    v_cvt_pk_bf16_f32 v51, v18, v19
    v_lshlrev_b32 v12, 16, v52
    v_and_b32 v13, 0xffff0000, v52
    v_mfma_f32_16x16x32_bf16 v[180:183], v[48:51], v[48:51], v[180:183]
    v_mfma_f32_16x16x32_bf16 v[176:179], v[48:51], v[32:35], v[176:179]
    v_lshlrev_b32 v14, 16, v53
    v_and_b32 v15, 0xffff0000, v53
    v_lshlrev_b32 v16, 16, v54
    v_and_b32 v17, 0xffff0000, v54
    v_lshlrev_b32 v18, 16, v55
    v_and_b32 v19, 0xffff0000, v55
    v_pk_mul_f32 v[12:13], v[12:13], s[26:27]
    v_pk_mul_f32 v[14:15], v[14:15], s[26:27]
    v_pk_mul_f32 v[16:17], v[16:17], s[26:27]
    v_pk_mul_f32 v[18:19], v[18:19], s[26:27]
    v_cvt_pk_bf16_f32 v52, v12, v13
    v_cvt_pk_bf16_f32 v53, v14, v15
    v_cvt_pk_bf16_f32 v54, v16, v17
    v_cvt_pk_bf16_f32 v55, v18, v19
    s_nop 1
    v_mfma_f32_16x16x32_bf16 v[180:183], v[52:55], v[52:55], v[180:183]
    v_mfma_f32_16x16x32_bf16 v[176:179], v[52:55], v[36:39], v[176:179]
    s_waitcnt vmcnt(7)
    buffer_load_dwordx4 v[88:91], v5, s[12:15], s19 offen offset:0 nt
    s_add_u32 s53, s19, 1048576
    s_waitcnt vmcnt(7)
    buffer_load_dwordx4 v[92:95], v5, s[12:15], s53 offen offset:0 nt
    s_waitcnt vmcnt(7)
    buffer_load_dwordx4 v[96:99], v5, s[12:15], s19 offen offset:2048 nt
    s_add_u32 s53, s19, 1048576
    s_waitcnt vmcnt(7)
    buffer_load_dwordx4 v[100:103], v5, s[12:15], s53 offen offset:2048 nt
    ds_read_b128 v[56:59], v6 offset:4096
    ds_read_b128 v[60:63], v7 offset:4096
    ds_read_b128 v[64:67], v8 offset:4096
    ds_read_b128 v[68:71], v9 offset:4096
    s_waitcnt lgkmcnt(0)
    v_lshlrev_b32 v12, 16, v56
    v_and_b32 v13, 0xffff0000, v56
    v_lshlrev_b32 v14, 16, v57
    v_and_b32 v15, 0xffff0000, v57
    v_lshlrev_b32 v16, 16, v58
    v_and_b32 v17, 0xffff0000, v58
    v_cndmask_b32 v20, 0, v180, s[32:33]
    v_cndmask_b32 v20, v20, v181, s[34:35]
    v_cndmask_b32 v20, v20, v182, s[36:37]
    v_cndmask_b32 v20, v20, v183, s[38:39]
    v_cvt_pk_bf16_f32 v20, 0, v20
    v_cvt_pk_bf16_f32 v176, 0, v176
    v_cvt_pk_bf16_f32 v177, 0, v177
    v_cvt_pk_bf16_f32 v178, 0, v178
    v_cvt_pk_bf16_f32 v179, 0, v179
    v_lshlrev_b32 v18, 16, v59
    v_and_b32 v19, 0xffff0000, v59
    v_mfma_f32_16x16x4_f32 v[176:179], v20, v11, v[176:179]
    v_pk_mul_f32 v[12:13], v[12:13], s[26:27]
    v_pk_mul_f32 v[14:15], v[14:15], s[26:27]
    v_pk_mul_f32 v[16:17], v[16:17], s[26:27]
    v_pk_mul_f32 v[18:19], v[18:19], s[26:27]
    v_cvt_pk_bf16_f32 v56, v12, v13
    v_cvt_pk_bf16_f32 v57, v14, v15
    v_cvt_pk_bf16_f32 v58, v16, v17
    v_cvt_pk_bf16_f32 v59, v18, v19
    v_lshlrev_b32 v12, 16, v60
    v_and_b32 v13, 0xffff0000, v60
    v_cvt_pk_bf16_f32 v176, 0, v176
    v_cvt_pk_bf16_f32 v177, 0, v177
    v_cvt_pk_bf16_f32 v178, 0, v178
    v_cvt_pk_bf16_f32 v179, 0, v179
    v_mul_f32 v176, s28, v176
    v_mul_f32 v177, s28, v177
    v_mul_f32 v178, s28, v178
    v_mul_f32 v179, s28, v179
    v_exp_f32 v176, v176
    v_exp_f32 v177, v177
    v_exp_f32 v178, v178
    v_exp_f32 v179, v179
    v_cvt_pk_bf16_f32 v176, 0, v176
    v_cvt_pk_bf16_f32 v177, 0, v177
    v_cvt_pk_bf16_f32 v178, 0, v178
    v_cvt_pk_bf16_f32 v179, 0, v179
    v_fmamk_f32 v176, v176, 0x3e800000, v10
    v_fmamk_f32 v177, v177, 0x3e800000, v10
    v_fmamk_f32 v178, v178, 0x3e800000, v10
    v_fmamk_f32 v179, v179, 0x3e800000, v10
    v_cvt_pk_bf16_f32 v192, v176, v177
    v_cvt_pk_bf16_f32 v193, v178, v179
    v_mfma_f32_16x16x32_bf16 v[188:191], v[56:59], v[56:59], 0
    v_mfma_f32_16x16x32_bf16 v[184:187], v[56:59], v[24:27], 0
    v_lshlrev_b32 v14, 16, v61
    v_and_b32 v15, 0xffff0000, v61
    v_lshlrev_b32 v16, 16, v62
    v_and_b32 v17, 0xffff0000, v62
    v_lshlrev_b32 v18, 16, v63
    v_and_b32 v19, 0xffff0000, v63
    v_pk_mul_f32 v[12:13], v[12:13], s[26:27]
    v_pk_mul_f32 v[14:15], v[14:15], s[26:27]
    v_pk_mul_f32 v[16:17], v[16:17], s[26:27]
    v_pk_mul_f32 v[18:19], v[18:19], s[26:27]
    v_cvt_pk_bf16_f32 v60, v12, v13
    v_cvt_pk_bf16_f32 v61, v14, v15
    v_cvt_pk_bf16_f32 v62, v16, v17
    v_cvt_pk_bf16_f32 v63, v18, v19
    v_lshlrev_b32 v12, 16, v64
    v_and_b32 v13, 0xffff0000, v64
    v_mfma_f32_16x16x32_bf16 v[188:191], v[60:63], v[60:63], v[188:191]
    v_mfma_f32_16x16x32_bf16 v[184:187], v[60:63], v[28:31], v[184:187]
    v_lshlrev_b32 v14, 16, v65
    v_and_b32 v15, 0xffff0000, v65
    v_lshlrev_b32 v16, 16, v66
    v_and_b32 v17, 0xffff0000, v66
    v_lshlrev_b32 v18, 16, v67
    v_and_b32 v19, 0xffff0000, v67
    v_pk_mul_f32 v[12:13], v[12:13], s[26:27]
    v_pk_mul_f32 v[14:15], v[14:15], s[26:27]
    v_pk_mul_f32 v[16:17], v[16:17], s[26:27]
    v_pk_mul_f32 v[18:19], v[18:19], s[26:27]
    v_cvt_pk_bf16_f32 v64, v12, v13
    v_cvt_pk_bf16_f32 v65, v14, v15
    v_cvt_pk_bf16_f32 v66, v16, v17
    v_cvt_pk_bf16_f32 v67, v18, v19
    v_lshlrev_b32 v12, 16, v68
    v_and_b32 v13, 0xffff0000, v68
    v_mfma_f32_16x16x32_bf16 v[188:191], v[64:67], v[64:67], v[188:191]
    v_mfma_f32_16x16x32_bf16 v[184:187], v[64:67], v[32:35], v[184:187]
    v_lshlrev_b32 v14, 16, v69
    v_and_b32 v15, 0xffff0000, v69
    v_lshlrev_b32 v16, 16, v70
    v_and_b32 v17, 0xffff0000, v70
    v_lshlrev_b32 v18, 16, v71
    v_and_b32 v19, 0xffff0000, v71
    v_pk_mul_f32 v[12:13], v[12:13], s[26:27]
    v_pk_mul_f32 v[14:15], v[14:15], s[26:27]
    v_pk_mul_f32 v[16:17], v[16:17], s[26:27]
    v_pk_mul_f32 v[18:19], v[18:19], s[26:27]
    v_cvt_pk_bf16_f32 v68, v12, v13
    v_cvt_pk_bf16_f32 v69, v14, v15
    v_cvt_pk_bf16_f32 v70, v16, v17
    v_cvt_pk_bf16_f32 v71, v18, v19
    s_nop 1
    v_mfma_f32_16x16x32_bf16 v[188:191], v[68:71], v[68:71], v[188:191]
    v_mfma_f32_16x16x32_bf16 v[184:187], v[68:71], v[36:39], v[184:187]
    s_nop 6
    v_cndmask_b32 v20, 0, v188, s[32:33]
    v_cndmask_b32 v20, v20, v189, s[34:35]
    v_cndmask_b32 v20, v20, v190, s[36:37]
    v_cndmask_b32 v20, v20, v191, s[38:39]
    v_cvt_pk_bf16_f32 v20, 0, v20
    v_cvt_pk_bf16_f32 v184, 0, v184
    v_cvt_pk_bf16_f32 v185, 0, v185
    v_cvt_pk_bf16_f32 v186, 0, v186
    v_cvt_pk_bf16_f32 v187, 0, v187
    s_nop 1
    v_mfma_f32_16x16x4_f32 v[184:187], v20, v11, v[184:187]
    s_nop 9
    v_cvt_pk_bf16_f32 v184, 0, v184
    v_cvt_pk_bf16_f32 v185, 0, v185
    v_cvt_pk_bf16_f32 v186, 0, v186
    v_cvt_pk_bf16_f32 v187, 0, v187
    v_mul_f32 v184, s28, v184
    v_mul_f32 v185, s28, v185
    v_mul_f32 v186, s28, v186
    v_mul_f32 v187, s28, v187
    v_exp_f32 v184, v184
    v_exp_f32 v185, v185
    v_exp_f32 v186, v186
    v_exp_f32 v187, v187
    v_cvt_pk_bf16_f32 v184, 0, v184
    v_cvt_pk_bf16_f32 v185, 0, v185
    v_cvt_pk_bf16_f32 v186, 0, v186
    v_cvt_pk_bf16_f32 v187, 0, v187
    v_fmamk_f32 v184, v184, 0x3e800000, v10
    v_fmamk_f32 v185, v185, 0x3e800000, v10
    v_fmamk_f32 v186, v186, 0x3e800000, v10
    v_fmamk_f32 v187, v187, 0x3e800000, v10
    v_cvt_pk_bf16_f32 v194, v184, v185
    v_cvt_pk_bf16_f32 v195, v186, v187
    s_nop 1
    v_mfma_f32_16x16x32_bf16 v[168:171], v[192:195], v[172:175], v[168:171]
    s_nop 7
    v_cndmask_b32 v20, v168, v169, s[82:83]
    v_cndmask_b32 v20, v20, v170, s[84:85]
    v_cndmask_b32 v20, v20, v171, s[86:87]
    s_waitcnt vmcnt(6)
    v_perm_b32 v104, v76, v72, s29
    v_perm_b32 v108, v76, v72, s30
    v_perm_b32 v112, v77, v73, s29
    v_perm_b32 v116, v77, v73, s30
    v_perm_b32 v120, v78, v74, s29
    v_perm_b32 v124, v78, v74, s30
    v_perm_b32 v128, v79, v75, s29
    v_perm_b32 v132, v79, v75, s30
    s_waitcnt vmcnt(4)
    v_perm_b32 v105, v84, v80, s29
    v_perm_b32 v109, v84, v80, s30
    v_perm_b32 v113, v85, v81, s29
    v_perm_b32 v117, v85, v81, s30
    v_perm_b32 v121, v86, v82, s29
    v_perm_b32 v125, v86, v82, s30
    v_perm_b32 v129, v87, v83, s29
    v_perm_b32 v133, v87, v83, s30
    s_waitcnt vmcnt(2)
    v_perm_b32 v106, v92, v88, s29
    v_perm_b32 v110, v92, v88, s30
    v_perm_b32 v114, v93, v89, s29
    v_perm_b32 v118, v93, v89, s30
    v_perm_b32 v122, v94, v90, s29
    v_perm_b32 v126, v94, v90, s30
    v_perm_b32 v130, v95, v91, s29
    v_perm_b32 v134, v95, v91, s30
    s_waitcnt vmcnt(0)
    v_perm_b32 v107, v100, v96, s29
    v_perm_b32 v111, v100, v96, s30
    v_perm_b32 v115, v101, v97, s29
    v_mfma_f32_16x16x32_bf16 v[136:139], v[192:195], v[104:107], v[136:139]
    v_perm_b32 v119, v101, v97, s30
    v_perm_b32 v123, v102, v98, s29
    v_mfma_f32_16x16x32_bf16 v[140:143], v[192:195], v[108:111], v[140:143]
    v_perm_b32 v127, v102, v98, s30
    v_perm_b32 v131, v103, v99, s29
    v_mfma_f32_16x16x32_bf16 v[144:147], v[192:195], v[112:115], v[144:147]
    v_perm_b32 v135, v103, v99, s30
    v_mfma_f32_16x16x32_bf16 v[148:151], v[192:195], v[116:119], v[148:151]
    v_mfma_f32_16x16x32_bf16 v[152:155], v[192:195], v[120:123], v[152:155]
    v_mul_f32 v200, v196, v136
    s_nop 0
    v_mul_f32 v201, v196, v140
    v_fmac_f32 v200, v197, v137
    v_mfma_f32_16x16x32_bf16 v[156:159], v[192:195], v[124:127], v[156:159]
    v_fmac_f32 v201, v197, v141
    v_fmac_f32 v200, v198, v138
    v_fmac_f32 v201, v198, v142
    v_mfma_f32_16x16x32_bf16 v[160:163], v[192:195], v[128:131], v[160:163]
    v_fmac_f32 v200, v199, v139
    v_fmac_f32 v201, v199, v143
    v_mul_f32 v202, v196, v144
    v_mfma_f32_16x16x32_bf16 v[164:167], v[192:195], v[132:135], v[164:167]
    v_mul_f32 v203, v196, v148
    v_fmac_f32 v202, v197, v145
    v_fmac_f32 v203, v197, v149
    v_fmac_f32 v202, v198, v146
    v_fmac_f32 v203, v198, v150
    v_fmac_f32 v202, v199, v147
    v_fmac_f32 v203, v199, v151
    v_mul_f32 v204, v196, v152
    v_mul_f32 v205, v196, v156
    v_fmac_f32 v204, v197, v153
    v_fmac_f32 v205, v197, v157
    v_fmac_f32 v204, v198, v154
    v_fmac_f32 v205, v198, v158
    v_fmac_f32 v204, v199, v155
    v_fmac_f32 v205, v199, v159
    v_mul_f32 v206, v196, v160
    v_mul_f32 v207, v196, v164
    v_fmac_f32 v206, v197, v161
    v_fmac_f32 v207, v197, v165
    v_fmac_f32 v206, v198, v162
    v_fmac_f32 v207, v198, v166
    v_fmac_f32 v206, v199, v163
    v_fmac_f32 v207, v199, v167
    v_permlane32_swap_b32 v200, v204
    v_permlane32_swap_b32 v201, v205
    v_permlane32_swap_b32 v202, v206
    v_permlane32_swap_b32 v203, v207
    v_add_f32 v200, v200, v204
    v_add_f32 v201, v201, v205
    v_add_f32 v202, v202, v206
    v_add_f32 v203, v203, v207
    s_nop 0
    v_permlane16_swap_b32 v200, v202
    v_permlane16_swap_b32 v201, v203
    v_add_f32 v200, v200, v202
    v_add_f32 v201, v201, v203
    v_mov_b32 v202, v20
    ds_write_b96 v22, v[200:202] offset:36864
    s_waitcnt lgkmcnt(0)
    s_barrier
    s_endpgm
L_helper:
    s_add_u32 s46, s46, s50
    s_addc_u32 s47, s47, 0
    s_add_u32 s44, s44, s50
    s_addc_u32 s45, s45, 0
    s_mov_b64 s[66:67], s[42:43]
    s_add_u32 s42, s42, s51
    s_addc_u32 s43, s43, 0
    s_lshr_b32 s50, s3, 1
    s_lshl_b32 s50, s50, 2
    s_add_u32 s40, s40, s50
    s_addc_u32 s41, s41, 0
    s_and_b32 s31, s3, 1
    s_lshl_b32 s31, s31, 4
    s_mov_b32 s26, 0x3e9837f0
    s_mov_b32 s27, 0x3e9837f0
    s_mov_b32 s28, 0x3fb8aa3b
    v_mov_b32 v10, 0x35860000
    s_waitcnt vmcnt(0)
    s_barrier
    global_load_dwordx4 v[40:43], v16, s[46:47] offset:0
    global_load_dwordx4 v[44:47], v16, s[46:47] offset:64
    global_load_dwordx4 v[48:51], v16, s[46:47] offset:128
    global_load_dwordx4 v[52:55], v16, s[46:47] offset:192
    ds_read_b128 v[24:27], v21 offset:32768
    ds_read_b128 v[28:31], v21 offset:33792
    ds_read_b128 v[32:35], v21 offset:34816
    ds_read_b128 v[36:39], v21 offset:35840
    s_and_b32 s52, s2, 1
    s_add_u32 s52, s52, 1
    v_mul_u32_u24 v22, 12, v0
    global_load_dwordx3 v[60:62], v22, s[42:43] sc1
    s_cmp_eq_u32 s52, 1
    s_cbranch_scc0 L_noflag
    s_lshl_b32 s24, 1, s31
    s_waitcnt vmcnt(0)
    s_atomic_add s24, s[40:41], 0
L_noflag:
    s_waitcnt vmcnt(0) lgkmcnt(0)
    v_lshlrev_b32 v12, 16, v40
    v_and_b32 v13, 0xffff0000, v40
    v_lshlrev_b32 v14, 16, v41
    v_and_b32 v15, 0xffff0000, v41
    v_lshlrev_b32 v16, 16, v42
    v_and_b32 v17, 0xffff0000, v42
    v_lshlrev_b32 v18, 16, v43
    v_and_b32 v19, 0xffff0000, v43
    v_pk_mul_f32 v[12:13], v[12:13], s[26:27]
    v_pk_mul_f32 v[14:15], v[14:15], s[26:27]
    v_pk_mul_f32 v[16:17], v[16:17], s[26:27]
    v_pk_mul_f32 v[18:19], v[18:19], s[26:27]
    v_cvt_pk_bf16_f32 v40, v12, v13
    v_cvt_pk_bf16_f32 v41, v14, v15
    v_cvt_pk_bf16_f32 v42, v16, v17
    v_cvt_pk_bf16_f32 v43, v18, v19
    v_lshlrev_b32 v12, 16, v44
    v_and_b32 v13, 0xffff0000, v44
    v_lshlrev_b32 v14, 16, v45
    v_and_b32 v15, 0xffff0000, v45
    v_lshlrev_b32 v16, 16, v46
    v_and_b32 v17, 0xffff0000, v46
    v_lshlrev_b32 v18, 16, v47
    v_and_b32 v19, 0xffff0000, v47
    v_pk_mul_f32 v[12:13], v[12:13], s[26:27]
    v_pk_mul_f32 v[14:15], v[14:15], s[26:27]
    v_pk_mul_f32 v[16:17], v[16:17], s[26:27]
    v_pk_mul_f32 v[18:19], v[18:19], s[26:27]
    v_cvt_pk_bf16_f32 v44, v12, v13
    v_cvt_pk_bf16_f32 v45, v14, v15
    v_cvt_pk_bf16_f32 v46, v16, v17
    v_cvt_pk_bf16_f32 v47, v18, v19
    v_lshlrev_b32 v12, 16, v48
    v_and_b32 v13, 0xffff0000, v48
    v_lshlrev_b32 v14, 16, v49
    v_and_b32 v15, 0xffff0000, v49
    v_lshlrev_b32 v16, 16, v50
    v_and_b32 v17, 0xffff0000, v50
    v_lshlrev_b32 v18, 16, v51
    v_and_b32 v19, 0xffff0000, v51
    v_pk_mul_f32 v[12:13], v[12:13], s[26:27]
    v_pk_mul_f32 v[14:15], v[14:15], s[26:27]
    v_pk_mul_f32 v[16:17], v[16:17], s[26:27]
    v_pk_mul_f32 v[18:19], v[18:19], s[26:27]
    v_cvt_pk_bf16_f32 v48, v12, v13
    v_cvt_pk_bf16_f32 v49, v14, v15
    v_cvt_pk_bf16_f32 v50, v16, v17
    v_cvt_pk_bf16_f32 v51, v18, v19
    v_lshlrev_b32 v12, 16, v52
    v_and_b32 v13, 0xffff0000, v52
    v_lshlrev_b32 v14, 16, v53
    v_and_b32 v15, 0xffff0000, v53
    v_lshlrev_b32 v16, 16, v54
    v_and_b32 v17, 0xffff0000, v54
    v_lshlrev_b32 v18, 16, v55
    v_and_b32 v19, 0xffff0000, v55
    v_pk_mul_f32 v[12:13], v[12:13], s[26:27]
    v_pk_mul_f32 v[14:15], v[14:15], s[26:27]
    v_pk_mul_f32 v[16:17], v[16:17], s[26:27]
    v_pk_mul_f32 v[18:19], v[18:19], s[26:27]
    v_cvt_pk_bf16_f32 v52, v12, v13
    v_cvt_pk_bf16_f32 v53, v14, v15
    v_cvt_pk_bf16_f32 v54, v16, v17
    v_cvt_pk_bf16_f32 v55, v18, v19
    v_mfma_f32_16x16x32_bf16 v[180:183], v[40:43], v[40:43], 0
    v_mfma_f32_16x16x32_bf16 v[196:199], v[24:27], v[40:43], 0
    v_mfma_f32_16x16x32_bf16 v[180:183], v[44:47], v[44:47], v[180:183]
    v_mfma_f32_16x16x32_bf16 v[196:199], v[28:31], v[44:47], v[196:199]
    v_mfma_f32_16x16x32_bf16 v[180:183], v[48:51], v[48:51], v[180:183]
    v_mfma_f32_16x16x32_bf16 v[196:199], v[32:35], v[48:51], v[196:199]
    v_mfma_f32_16x16x32_bf16 v[180:183], v[52:55], v[52:55], v[180:183]
    v_mfma_f32_16x16x32_bf16 v[196:199], v[36:39], v[52:55], v[196:199]
    s_nop 6
    v_cvt_pk_bf16_f32 v20, 0, v180
    v_cvt_pk_bf16_f32 v196, 0, v196
    v_cvt_pk_bf16_f32 v197, 0, v197
    v_cvt_pk_bf16_f32 v198, 0, v198
    v_cvt_pk_bf16_f32 v199, 0, v199
    v_fma_f32 v196, v20, -0.5, v196
    v_fma_f32 v197, v20, -0.5, v197
    v_fma_f32 v198, v20, -0.5, v198
    v_fma_f32 v199, v20, -0.5, v199
    v_cvt_pk_bf16_f32 v196, 0, v196
    v_cvt_pk_bf16_f32 v197, 0, v197
    v_cvt_pk_bf16_f32 v198, 0, v198
    v_cvt_pk_bf16_f32 v199, 0, v199
    v_mul_f32 v196, s28, v196
    v_mul_f32 v197, s28, v197
    v_mul_f32 v198, s28, v198
    v_mul_f32 v199, s28, v199
    v_exp_f32 v196, v196
    v_exp_f32 v197, v197
    v_exp_f32 v198, v198
    v_exp_f32 v199, v199
    v_cvt_pk_bf16_f32 v196, 0, v196
    v_cvt_pk_bf16_f32 v197, 0, v197
    v_cvt_pk_bf16_f32 v198, 0, v198
    v_cvt_pk_bf16_f32 v199, 0, v199
    v_fmamk_f32 v196, v196, 0x3e800000, v10
    v_fmamk_f32 v197, v197, 0x3e800000, v10
    v_fmamk_f32 v198, v198, 0x3e800000, v10
    v_fmamk_f32 v199, v199, 0x3e800000, v10
    v_cvt_pk_bf16_f32 v196, 0, v196
    v_cvt_pk_bf16_f32 v197, 0, v197
    v_cvt_pk_bf16_f32 v198, 0, v198
    v_cvt_pk_bf16_f32 v199, 0, v199
    ds_write_b128 v21, v[196:199] offset:40960
    s_lshr_b32 s50, s2, 5
    s_mul_i32 s50, s50, 4096
    s_add_u32 s50, s50, 0x100000
    s_add_u32 s66, s66, s50
    s_addc_u32 s67, s67, 0
    s_load_dword s68, s[66:67], 0 glc
    s_mov_b32 s73, 0x9311254
    s_bitcmp1_b32 s2, 0
    s_cselect_b32 s74, 0x54, 0
    v_mov_b32 v18, 0
    s_waitcnt lgkmcnt(0)
L_hc:
    s_flbit_i32_b32 s22, s73
    s_sub_u32 s22, 31, s22
    s_bitset0_b32 s73, s22
    s_mov_b32 s78, 0x21000000
    s_mov_b32 s79, 0xc9754322
    s_cmp_le_u32 s22, 22
    s_cselect_b32 s78, 0x11100000, s78
    s_cselect_b32 s79, 0xc9754322, s79
    s_lshl_b32 s53, s22, 2
    s_bitcmp1_b32 s74, s22
    s_cselect_b32 s75, 1, 0
    s_sub_u32 s53, s53, s75
    s_mov_b32 s69, 1
    s_barrier
    s_atomic_add s69, s[66:67], 0 glc
    s_load_dword s80, s[66:67], 0x100 glc
    s_add_u32 s66, s66, 256
    s_addc_u32 s67, s67, 0
    s_waitcnt lgkmcnt(0)
    s_sub_u32 s69, s69, s68
    s_mov_b32 s68, s80
    s_max_i32 s69, s69, 0
    s_min_i32 s69, s69, 31
    s_lshr_b32 s69, s69, 1
    s_lshl_b32 s69, s69, 2
    s_lshr_b64 s[78:79], s[78:79], s69
    s_and_b32 s78, s78, 15
    s_cmp_eq_u32 s78, 0
    s_cselect_b32 s75, 255, 0
    s_sub_u32 s53, s53, s78
    s_max_i32 s53, s53, 0
    s_or_b32 s53, s53, s75
    v_mov_b32 v17, s53
    ds_write_b32 v18, v17 offset:41984
    s_cmp_lg_u32 s73, 0
    s_cbranch_scc1 L_hc
    v_mov_b32 v172, 1.0
    s_mov_b32 s82, 0x22222222
    s_mov_b32 s83, 0x22222222
    s_mov_b32 s84, 0x44444444
    s_mov_b32 s85, 0x44444444
    s_mov_b32 s86, 0x88888888
    s_mov_b32 s87, 0x88888888
    v_cndmask_b32 v176, v196, v197, s[82:83]
    v_cndmask_b32 v176, v176, v198, s[84:85]
    v_cndmask_b32 v176, v176, v199, s[86:87]
    s_waitcnt lgkmcnt(0)
    s_barrier
    s_cmp_eq_u32 s52, 1
    s_cbranch_scc1 L_poll
L_flagchk:
    v_mov_b32 v18, 0
    global_load_dword v19, v18, s[40:41] sc1
    s_waitcnt vmcnt(0)
    v_readfirstlane_b32 s24, v19
    s_nop 0
    s_lshr_b32 s50, s24, s31
    s_and_b32 s50, s50, 0xff
    s_cbranch_scc0 L_flagchk
    v_not_b32 v60, v60
    v_not_b32 v61, v61
    v_not_b32 v62, v62
    s_branch L_hwait
L_poll:
    global_load_dwordx3 v[56:58], v22, s[42:43] sc1
    s_waitcnt vmcnt(0)
    v_xor_b32 v12, v56, v60
    v_xor_b32 v13, v57, v61
    v_xor_b32 v14, v58, v62
    v_and_b32 v12, v12, v13
    v_and_b32 v14, 1, v14
    v_and_b32 v12, v12, v14
    v_cmp_eq_u32 vcc, 0, v12
    s_cbranch_vccnz L_poll
    v_and_b32 v56, -2, v56
    v_and_b32 v57, -2, v57
    v_and_b32 v58, -2, v58
L_hwait:
    s_barrier
    ds_read_b96 v[72:74], v21 offset:36864
    ds_read_b96 v[76:78], v21 offset:37888
    ds_read_b96 v[80:82], v21 offset:38912
    ds_read_b96 v[84:86], v21 offset:39936
    s_waitcnt lgkmcnt(2)
    v_add_f32 v200, v72, v76
    v_add_f32 v201, v73, v77
    v_add_f32 v202, v74, v78
    s_waitcnt lgkmcnt(0)
    v_add_f32 v80, v80, v84
    v_add_f32 v81, v81, v85
    v_add_f32 v82, v82, v86
    v_add_f32 v200, v200, v80
    v_add_f32 v201, v201, v81
    v_add_f32 v202, v202, v82
    s_cmp_eq_u32 s52, 1
    s_cbranch_scc1 L_cons
    v_bfi_b32 v200, 1, v60, v200
    v_bfi_b32 v201, 1, v61, v201
    v_bfi_b32 v202, 1, v62, v202
    global_store_dwordx3 v22, v[200:202], s[42:43] sc1
    s_endpgm
L_cons:
    s_nop 1
    v_add_f32 v200, v200, v56
    v_add_f32 v201, v201, v57
    v_add_f32 v202, v202, v58
    v_cvt_pk_bf16_f32 v200, 0, v200
    v_cvt_pk_bf16_f32 v201, 0, v201
    v_cvt_pk_bf16_f32 v202, 0, v202
    v_mul_f32 v202, v202, v176
    s_nop 1
    v_mfma_f32_16x16x4_f32 v[180:183], v172, v202, 0
    s_nop 9
    v_add_f32_dpp v202, v180, v180 quad_perm:[1,0,3,2] row_mask:0xf bank_mask:0xf
    s_nop 1
    v_add_f32_dpp v202, v202, v202 quad_perm:[2,3,0,1] row_mask:0xf bank_mask:0xf
    v_cvt_pk_bf16_f32 v202, 0, v202
    v_add_f32 v202, v202, v10
    v_cvt_pk_bf16_f32 v202, 0, v202
    v_div_scale_f32 v40, s[50:51], v202, v202, v200
    v_div_scale_f32 v45, s[54:55], v202, v202, v201
    v_rcp_f32 v41, v40
    v_rcp_f32 v46, v45
    v_div_scale_f32 v42, vcc, v200, v202, v200
    v_div_scale_f32 v47, s[54:55], v201, v202, v201
    v_fma_f32 v43, -v40, v41, 1.0
    v_fma_f32 v48, -v45, v46, 1.0
    v_fmac_f32 v41, v43, v41
    v_fmac_f32 v46, v48, v46
    v_mul_f32 v43, v42, v41
    v_mul_f32 v48, v47, v46
    v_fma_f32 v44, -v40, v43, v42
    v_fma_f32 v49, -v45, v48, v47
    v_fmac_f32 v43, v44, v41
    v_fmac_f32 v48, v49, v46
    v_fma_f32 v40, -v40, v43, v42
    v_fma_f32 v45, -v45, v48, v47
    v_div_fmas_f32 v40, v40, v41, v43
    s_mov_b64 vcc, s[54:55]
    v_div_fixup_f32 v200, v40, v202, v200
    v_div_fmas_f32 v45, v45, v46, v48
    v_div_fixup_f32 v201, v45, v202, v201
    v_cvt_pk_bf16_f32 v200, v200, v201
    global_store_dword v23, v200, s[44:45] sc1
L_fin:
L_end:
    s_endpgm
.section .rodata,"a"
.p2align 6
.amdhsa_kernel standalone__linear_kernel_rfa__decode_kernel
  .amdhsa_next_free_vgpr 208
  .amdhsa_next_free_sgpr 88
  .amdhsa_accum_offset 208
  .amdhsa_group_segment_fixed_size 0
  .amdhsa_kernarg_size 56
  .amdhsa_user_sgpr_count 2
  .amdhsa_user_sgpr_kernarg_segment_ptr 1
  .amdhsa_system_sgpr_workgroup_id_x 1
  .amdhsa_float_denorm_mode_32 3
.end_amdhsa_kernel
```
